```python
import torch

def _softmax(x, axis=-1):
    return torch.softmax(x, dim=axis)
def _gelu(x):
    return torch.nn.functional.gelu(x, approximate="tanh")
def _silu(x):
    return torch.nn.functional.silu(x)
def _sigmoid(x):
    return torch.sigmoid(x)
def _layernorm(x, axis=-1, eps=1e-5):
    m = x.mean(dim=axis, keepdim=True)
    v = x.var(dim=axis, keepdim=True, unbiased=False)
    return (x - m) / torch.sqrt(v + eps)
def _scatter_add(tgt, idx, src, axis=0):
    return tgt.clone().index_add_(axis, idx, src)
def _segment_sum(src, seg, n):
    out = torch.zeros((n,) + src.shape[1:], dtype=src.dtype)
    return out.index_add_(0, seg, src)
def _pad(x, pw):
    flat = tuple(v for pair in reversed(pw) for v in pair)
    return torch.nn.functional.pad(x, flat)

kernel_name = 'standalone__rezero__sampling'

def setup_inputs():

    _w = (lambda a: (lambda t: t.to(torch.bfloat16) if t.is_floating_point() else t)(torch.as_tensor(a)))
    B, S, D = 512, 32, 640
    return {
        "x": _w((lambda *s: torch.randn(*s, dtype=torch.bfloat16) * 0.05)(B, S, D)),
        "fx": _w((lambda *s: torch.randn(*s, dtype=torch.bfloat16) * 0.8)(B, S, D)),
        "alpha": _w((lambda *s: torch.randn(*s, dtype=torch.bfloat16) * 0.8)(1) * 0.1),
    }

def reference(x, fx, alpha):
    return x + alpha * fx
```

```asm
; @launch grid=(256,1,1) block=(1024,1,1) lds=0
.amdgcn_target "amdgcn-amd-amdhsa--gfx950"
.text
.globl standalone__rezero__sampling_kernel
.p2align 8
.type standalone__rezero__sampling_kernel,@function
standalone__rezero__sampling_kernel:
    s_load_dwordx8 s[4:11], s[0:1], 0
    s_cmp_ge_u32 s2, 256
    s_cbranch_scc1 L_done
    s_lshl_b32 s3, s2, 14
    v_lshl_add_u32 v0, v0, 4, s3
    s_waitcnt lgkmcnt(0)
    global_load_dwordx4 v[2:5], v0, s[6:7] nt
    global_load_dwordx4 v[6:9], v0, s[4:5] nt
    s_load_dword s12, s[8:9], 0
    s_mov_b32 s14, 4
    s_mov_b32 s15, 0xffff0000
    s_mov_b32 s16, 4194304
    v_add_u32 v1, s16, v0
    s_waitcnt lgkmcnt(0)
    s_lshl_b32 s12, s12, 16
    s_mov_b32 s13, s12
    s_waitcnt vmcnt(0)
    s_branch L_body
L_loop:
    s_waitcnt vmcnt(1)
L_body:
    v_lshlrev_b32 v10, 16, v2
    v_and_b32 v11, s15, v2
    v_lshlrev_b32 v12, 16, v3
    v_and_b32 v13, s15, v3
    v_lshlrev_b32 v14, 16, v4
    v_and_b32 v15, s15, v4
    v_lshlrev_b32 v16, 16, v5
    v_and_b32 v17, s15, v5
    v_lshlrev_b32 v18, 16, v6
    v_and_b32 v19, s15, v6
    v_lshlrev_b32 v20, 16, v7
    v_and_b32 v21, s15, v7
    v_lshlrev_b32 v22, 16, v8
    v_and_b32 v23, s15, v8
    v_lshlrev_b32 v24, 16, v9
    v_and_b32 v25, s15, v9
    s_cmp_eq_u32 s14, 0
    s_cbranch_scc1 L_noload
    global_load_dwordx4 v[2:5], v1, s[6:7] nt
    global_load_dwordx4 v[6:9], v1, s[4:5] nt
L_noload:
    v_pk_mul_f32 v[10:11], v[10:11], s[12:13]
    v_pk_mul_f32 v[12:13], v[12:13], s[12:13]
    v_pk_mul_f32 v[14:15], v[14:15], s[12:13]
    v_pk_mul_f32 v[16:17], v[16:17], s[12:13]
    v_cvt_pk_bf16_f32 v26, v10, v11
    v_cvt_pk_bf16_f32 v27, v12, v13
    v_cvt_pk_bf16_f32 v28, v14, v15
    v_cvt_pk_bf16_f32 v29, v16, v17
    v_lshlrev_b32 v10, 16, v26
    v_and_b32 v11, s15, v26
    v_lshlrev_b32 v12, 16, v27
    v_and_b32 v13, s15, v27
    v_lshlrev_b32 v14, 16, v28
    v_and_b32 v15, s15, v28
    v_lshlrev_b32 v16, 16, v29
    v_and_b32 v17, s15, v29
    v_pk_add_f32 v[10:11], v[18:19], v[10:11]
    v_pk_add_f32 v[12:13], v[20:21], v[12:13]
    v_pk_add_f32 v[14:15], v[22:23], v[14:15]
    v_pk_add_f32 v[16:17], v[24:25], v[16:17]
    v_cvt_pk_bf16_f32 v26, v10, v11
    v_cvt_pk_bf16_f32 v27, v12, v13
    v_cvt_pk_bf16_f32 v28, v14, v15
    v_cvt_pk_bf16_f32 v29, v16, v17
    global_store_dwordx4 v0, v[26:29], s[10:11] sc0 sc1
    s_sub_u32 s14, s14, 1
    s_nop 0
    v_mov_b32 v0, v1
    v_add_u32 v1, s16, v1
    s_cbranch_scc0 L_loop
L_done:
    s_endpgm
.section .rodata,"a"
.p2align 6
.amdhsa_kernel standalone__rezero__sampling_kernel
  .amdhsa_next_free_vgpr 32
  .amdhsa_next_free_sgpr 24
  .amdhsa_accum_offset 32
  .amdhsa_group_segment_fixed_size 0
  .amdhsa_kernarg_size 48
  .amdhsa_user_sgpr_count 2
  .amdhsa_user_sgpr_kernarg_segment_ptr 1
  .amdhsa_system_sgpr_workgroup_id_x 1
  .amdhsa_float_denorm_mode_32 3
  .amdhsa_float_denorm_mode_16_64 3
.end_amdhsa_kernel
```

```asm
; @launch grid=(256,1,1) block=(1024,1,1) lds=0
.amdgcn_target "amdgcn-amd-amdhsa--gfx950"
.text
.globl standalone__rezero__sampling_kernel
.p2align 8
.type standalone__rezero__sampling_kernel,@function
standalone__rezero__sampling_kernel:
    s_load_dwordx8 s[4:11], s[0:1], 0
    s_cmp_ge_u32 s2, 256
    s_cbranch_scc1 L_done
    s_lshl_b32 s3, s2, 14
    v_lshl_add_u32 v0, v0, 4, s3
    s_waitcnt lgkmcnt(0)
    global_load_dwordx4 v[2:5], v0, s[6:7] nt
    global_load_dwordx4 v[6:9], v0, s[4:5] nt
    s_load_dword s17, s[8:9], 0
    s_mov_b32 s14, 4
    s_mov_b32 s15, 0xffff0000
    s_mov_b32 s16, 0x400000
    v_add_u32 v1, s16, v0
    s_waitcnt vmcnt(0)
    s_branch L_body
L_loop:
    s_waitcnt vmcnt(1)
L_body:
    v_lshlrev_b32 v10, 16, v2
    v_and_b32 v11, s15, v2
    v_lshlrev_b32 v12, 16, v3
    v_and_b32 v13, s15, v3
    v_lshlrev_b32 v14, 16, v4
    v_and_b32 v15, s15, v4
    v_lshlrev_b32 v16, 16, v5
    v_and_b32 v17, s15, v5
    v_lshlrev_b32 v18, 16, v6
    v_and_b32 v19, s15, v6
    v_lshlrev_b32 v20, 16, v7
    v_and_b32 v21, s15, v7
    v_lshlrev_b32 v22, 16, v8
    v_and_b32 v23, s15, v8
    v_lshlrev_b32 v24, 16, v9
    v_and_b32 v25, s15, v9
    s_cmp_eq_u32 s14, 0
    s_cbranch_scc1 L_noload
    global_load_dwordx4 v[2:5], v1, s[6:7] nt
    global_load_dwordx4 v[6:9], v1, s[4:5] nt
L_noload:
    s_waitcnt lgkmcnt(0)
    s_lshl_b32 s12, s17, 16
    s_lshl_b32 s13, s17, 16
    v_pk_mul_f32 v[10:11], v[10:11], s[12:13]
    v_pk_mul_f32 v[12:13], v[12:13], s[12:13]
    v_pk_mul_f32 v[14:15], v[14:15], s[12:13]
    v_pk_mul_f32 v[16:17], v[16:17], s[12:13]
    v_cvt_pk_bf16_f32 v26, v10, v11
    v_cvt_pk_bf16_f32 v27, v12, v13
    v_cvt_pk_bf16_f32 v28, v14, v15
    v_cvt_pk_bf16_f32 v29, v16, v17
    v_lshlrev_b32 v10, 16, v26
    v_and_b32 v11, s15, v26
    v_lshlrev_b32 v12, 16, v27
    v_and_b32 v13, s15, v27
    v_lshlrev_b32 v14, 16, v28
    v_and_b32 v15, s15, v28
    v_lshlrev_b32 v16, 16, v29
    v_and_b32 v17, s15, v29
    v_pk_add_f32 v[10:11], v[18:19], v[10:11]
    v_pk_add_f32 v[12:13], v[20:21], v[12:13]
    v_pk_add_f32 v[14:15], v[22:23], v[14:15]
    v_pk_add_f32 v[16:17], v[24:25], v[16:17]
    v_cvt_pk_bf16_f32 v26, v10, v11
    v_cvt_pk_bf16_f32 v27, v12, v13
    v_cvt_pk_bf16_f32 v28, v14, v15
    v_cvt_pk_bf16_f32 v29, v16, v17
    global_store_dwordx4 v0, v[26:29], s[10:11] sc0 sc1
    s_sub_u32 s14, s14, 1
    s_nop 0
    v_mov_b32 v0, v1
    v_add_u32 v1, s16, v1
    s_cbranch_scc0 L_loop
L_done:
    s_endpgm
.section .rodata,"a"
.p2align 6
.amdhsa_kernel standalone__rezero__sampling_kernel
  .amdhsa_next_free_vgpr 32
  .amdhsa_next_free_sgpr 24
  .amdhsa_accum_offset 32
  .amdhsa_group_segment_fixed_size 0
  .amdhsa_kernarg_size 48
  .amdhsa_user_sgpr_count 2
  .amdhsa_user_sgpr_kernarg_segment_ptr 1
  .amdhsa_system_sgpr_workgroup_id_x 1
  .amdhsa_float_denorm_mode_32 3
  .amdhsa_float_denorm_mode_16_64 3
.end_amdhsa_kernel
```
